```python
import torch

def _softmax(x, axis=-1):
    return torch.softmax(x, dim=axis)
def _gelu(x):
    return torch.nn.functional.gelu(x, approximate="tanh")
def _silu(x):
    return torch.nn.functional.silu(x)
def _sigmoid(x):
    return torch.sigmoid(x)
def _layernorm(x, axis=-1, eps=1e-5):
    m = x.mean(dim=axis, keepdim=True)
    v = x.var(dim=axis, keepdim=True, unbiased=False)
    return (x - m) / torch.sqrt(v + eps)
def _scatter_add(tgt, idx, src, axis=0):
    return tgt.clone().index_add_(axis, idx, src)
def _segment_sum(src, seg, n):
    out = torch.zeros((n,) + src.shape[1:], dtype=src.dtype)
    return out.index_add_(0, seg, src)
def _pad(x, pw):
    flat = tuple(v for pair in reversed(pw) for v in pair)
    return torch.nn.functional.pad(x, flat)

kernel_name = 'standalone__linear_kernel_rfa__decode'

def setup_inputs():

    _w = (lambda a: (lambda t: t.to(torch.bfloat16) if t.is_floating_point() else t)(torch.as_tensor(a)))
    B, H, Sq, Sk, D, M = 8, 32, 1, 4096, 128, 64
    return {
        "q": _w((lambda *s: torch.randn(*s, dtype=torch.bfloat16) * 0.2)(B, H, Sq, D)),
        "k": _w((lambda *s: torch.randn(*s, dtype=torch.bfloat16) * 1.6)(B, H, Sk, D)),
        "v": _w((lambda *s: torch.randn(*s, dtype=torch.bfloat16) * 1.6)(B, H, Sk, D)),
        "omega": _w((lambda *s: torch.randn(*s, dtype=torch.bfloat16) * 1.6)(M, D)),
    }

def reference(q, k, v, omega):
    d = q.shape[-1]
    m = omega.shape[0]
    scale = float(d) ** -0.25
    qs = q * scale
    ks = k * scale
    q_proj = torch.einsum("bhsd,md->bhsm", qs, omega)
    k_proj = torch.einsum("bhsd,md->bhsm", ks, omega)
    q_sq = 0.5 * torch.einsum("bhsd,bhsd->bhs", qs, qs)[..., None]
    k_sq = 0.5 * torch.einsum("bhsd,bhsd->bhs", ks, ks)[..., None]
    inv_sqrt_m = float(m) ** -0.5
    phi_q = torch.exp(q_proj - q_sq) * inv_sqrt_m + 1e-6
    phi_k = torch.exp(k_proj - k_sq) * inv_sqrt_m + 1e-6
    kv = torch.einsum("bhsm,bhsd->bhmd", phi_k, v)
    z  = torch.einsum("bhsm->bhm", phi_k)
    num = torch.einsum("bhqm,bhmd->bhqd", phi_q, kv)
    den = torch.einsum("bhqm,bhm->bhq", phi_q, z)[..., None] + 1e-6
    return num / den
```

```asm
; @launch grid=(256,1,1) block=(576,1,1) lds=150016
    .amdgcn_target "amdgcn-amd-amdhsa--gfx950"
    .text
    .globl standalone__linear_kernel_rfa__decode_kernel
    .p2align 8
    .type standalone__linear_kernel_rfa__decode_kernel,@function
standalone__linear_kernel_rfa__decode_kernel:
    s_load_dwordx8 s[4:11], s[0:1], 0
    v_readfirstlane_b32 s3, v0
    v_and_b32 v12, 48, v0
    v_lshlrev_b32 v8, 4, v0
    v_lshlrev_b32 v12, 2, v12
    s_lshr_b32 s15, s2, 8
    s_cbranch_scc1 L_done
    s_lshl1_add_u32 s15, s2, 2
    s_and_b32 s15, s15, 4
    s_xor_b32 s2, s2, s15
    v_xor_b32 v8, v8, v12
    s_lshl_b32 s19, 1, 17
    s_lshr_b32 s3, s3, 6
    s_cbranch_scc1 L_cons
    v_xor_b32 v9, 1040, v8
    v_xor_b32 v10, 6176, v8
    v_xor_b32 v11, 7216, v8
    s_lshl_b32 s14, s2, 20
    s_lshl_b32 s18, 1, 20
    s_mov_b32 m0, 0
    s_mov_b32 s37, 0
    s_waitcnt lgkmcnt(0)
    s_add_u32 s16, s6, s14
    s_addc_u32 s17, s7, 0
L_s:
    buffer_load_dwordx4 v8, s[16:19], s37 offen offset:0 nt lds
    buffer_load_dwordx4 v9, s[16:19], s37 offen offset:1024 nt lds
    buffer_load_dwordx4 v10, s[16:19], s37 offen offset:2048 nt lds
    buffer_load_dwordx4 v11, s[16:19], s37 offen offset:3072 nt lds
    s_add_u32 m0, m0, 4096
    s_add_u32 s37, s37, 16384
    s_cmp_lg_u32 s37, 0x14000
    s_cbranch_scc1 L_s
    s_load_dwordx4 s[20:23], s[0:1], 40
    s_setprio 3
    s_getreg_b32 s15, hwreg(HW_REG_XCC_ID, 0, 3)
    s_getreg_b32 s24, hwreg(HW_REG_HW_ID, 8, 4)
    s_getreg_b32 s13, hwreg(HW_REG_HW_ID, 13, 2)
    s_mul_i32 s15, s15, 1280
    s_add_u32 s15, s15, 65536
    s_lshl4_add_u32 s24, s13, s24
    v_lshl_add_u32 v13, v0, 2, s15
    s_lshl2_add_u32 s13, s24, s15
    v_mov_b32 v12, s13
    s_add_u32 s15, s15, 252
    v_mov_b32 v14, s15
    v_mov_b32 v15, 0x1005
    v_mov_b32 v16, 0
    s_mov_b32 s26, 0
    s_mov_b32 s25, 0
    s_mov_b32 s30, 0
    s_mov_b32 s34, 0
    s_waitcnt lgkmcnt(0)
    global_store_dword v13, v16, s[22:23]
L_w3:
    s_waitcnt vmcnt(27)
    buffer_load_dwordx4 v8, s[16:19], s37 offen offset:0 nt lds
    s_waitcnt vmcnt(26)
    buffer_load_dwordx4 v9, s[16:19], s37 offen offset:1024 nt lds
    s_waitcnt vmcnt(26)
    buffer_load_dwordx4 v10, s[16:19], s37 offen offset:2048 nt lds
    s_waitcnt vmcnt(26)
    buffer_load_dwordx4 v11, s[16:19], s37 offen offset:3072 nt lds
    v_add_u32 v15, 1, v15
    s_add_u32 m0, m0, 4096
    s_add_u32 s37, s37, 16384
    global_store_dword v12, v15, s[22:23]
    s_andn2_b32 s15, 0xc000, s37
    s_cbranch_scc1 L_w3
    s_waitcnt vmcnt(27)
    buffer_load_dwordx4 v8, s[16:19], s37 offen offset:0 nt lds
    v_mov_b32 v17, v16
    s_nop 0
    v_readlane_b32 s36, v17, s24
    v_readlane_b32 s35, v17, 63
    s_nop 0
    v_subrev_u32 v17, s36, v17
    v_writelane_b32 v17, 0, 63
    s_waitcnt vmcnt(26)
    buffer_load_dwordx4 v9, s[16:19], s37 offen offset:1024 nt lds
    v_add_u32_dpp v17, v17, v17 row_shr:1 row_mask:0xf bank_mask:0xf bound_ctrl:1
    s_nop 1
    v_add_u32_dpp v17, v17, v17 row_shr:2 row_mask:0xf bank_mask:0xf bound_ctrl:1
    s_waitcnt vmcnt(26)
    buffer_load_dwordx4 v10, s[16:19], s37 offen offset:2048 nt lds
    v_add_u32_dpp v17, v17, v17 row_shr:4 row_mask:0xf bank_mask:0xf bound_ctrl:1
    s_nop 1
    v_add_u32_dpp v17, v17, v17 row_shr:8 row_mask:0xf bank_mask:0xf bound_ctrl:1
    s_waitcnt vmcnt(26)
    buffer_load_dwordx4 v11, s[16:19], s37 offen offset:3072 nt lds
    v_add_u32_dpp v17, v17, v17 row_bcast:15 row_mask:0xa bank_mask:0xf
    v_add_u32 v15, 1, v15
    s_add_u32 m0, m0, 4096
    v_add_u32_dpp v17, v17, v17 row_bcast:31 row_mask:0xc bank_mask:0xf
L_se:
    global_store_dword v12, v15, s[22:23]
    v_readlane_b32 s27, v17, 63
    global_load_dword v16, v13, s[22:23] nt
    s_add_u32 s37, s37, 16384
    s_add_u32 s27, s27, s35
    s_add_u32 s27, s27, s25
    s_and_b32 s27, s27, s26
    s_ashr_i32 s31, s27, 4
    s_bitcmp1_b32 s37, 16
    s_cbranch_scc0 L_st
    s_cmp_eq_u32 s30, 63
    s_cbranch_scc1 L_le
L_top:
    s_cmp_eq_i32 s31, 0
    s_cbranch_scc1 L_w3
    s_cmp_eq_i32 s31, 1
    s_cbranch_scc1 L_w4
    s_cmp_eq_i32 s31, -1
    s_cbranch_scc1 L_w2
    s_cmp_eq_i32 s31, 2
    s_cbranch_scc1 L_w5
    s_cmp_eq_i32 s31, -2
    s_cbranch_scc1 L_w1
    s_cmp_eq_i32 s31, 3
    s_cbranch_scc1 L_w6
    s_cmp_le_i32 s31, -3
    s_cbranch_scc1 L_w0
    s_cmp_eq_i32 s31, 4
    s_cbranch_scc1 L_w7
    s_cmp_eq_i32 s31, 5
    s_cbranch_scc1 L_w8
    s_branch L_w9
L_st:
    s_and_b32 m0, m0, 0x1ffff
    s_add_u32 s30, s30, 1
    s_mul_i32 s37, s30, 0x20100
    s_and_b32 s37, s37, 0xe1000
    s_and_b32 s15, s30, 13
    s_bcnt1_i32_b32 s15, s15
    s_bitcmp1_b32 s15, 0
    s_cselect_b32 s15, 1024, 0
    s_or_b32 s37, s37, s15
    s_cmp_le_u32 s30, 4
    s_cbranch_scc1 L_early
    s_sub_u32 s15, s30, s32
    s_add_u32 s15, s15, 1
    s_cmp_le_u32 s15, 2
    s_cbranch_scc1 L_rep
L_c2:
    s_barrier
    s_and_b32 s15, s30, 31
    s_cbranch_scc1 L_top
    s_add_u32 s16, s8, s14
    s_addc_u32 s17, s9, 0
    s_add_u32 s25, s25, -4
    s_branch L_top
L_le:
    s_barrier
    s_waitcnt vmcnt(16)
    s_barrier
    s_waitcnt vmcnt(0)
    s_barrier
    s_endpgm
L_early:
    s_cmp_eq_u32 s30, 3
    s_cbranch_scc1 L_e3
    s_cmp_gt_u32 s30, 3
    s_cselect_b32 s26, -1, 0
L_e4:
    s_bitcmp1_b32 s30, 0
    s_cbranch_scc1 L_top
    s_waitcnt vmcnt(32)
    s_branch L_c2
L_e3:
    v_sub_u32 v17, v16, v15
    v_add_u32 v17, 32, v17
    v_cmp_gt_u32 vcc, 64, v17
    s_nop 0
    s_bcnt1_i32_b64 s25, vcc
    s_bfm_b64 s[12:13], s24, 0
    s_and_b64 s[12:13], s[12:13], vcc
    s_bcnt1_i32_b64 s32, s[12:13]
    s_lshl_b32 s32, s32, 1
    s_bitset1_b32 vcc_hi, 31
    s_lshr_b32 s25, s25, 1
    s_add_u32 s25, s25, 15
    v_cndmask_b32 v13, v12, v13, vcc
    s_branch L_e4
L_rep:
    s_cmp_eq_u32 s15, 1
    s_cbranch_scc1 L_r1
    s_cmp_eq_u32 s15, 2
    s_cbranch_scc1 L_r2
    s_cmp_ge_u32 s30, 12
    s_cselect_b32 s15, 128, 0
    s_cmp_ge_u32 s30, 61
    s_cbranch_scc1 L_c2
    s_load_dword s34, s[20:21], s15
    s_branch L_c2
L_r1:
    s_waitcnt lgkmcnt(0)
    s_cmp_lg_u32 s34, 1
    s_cbranch_scc1 L_c2
    s_mul_i32 s15, s30, 768
    s_add_u32 s15, s15, 16384
    s_cmp_lt_u32 s30, 32
    s_cselect_b32 s33, 6, 4
    s_cselect_b32 s12, 21, 14
    s_atomic_add s33, s[22:23], s15 glc
    s_branch L_c2
L_r2:
    s_cmp_lg_u32 s34, 1
    s_cbranch_scc1 L_c2
    s_ashr_i32 s15, s35, 1
    s_sub_u32 s15, s15, s12
    s_waitcnt lgkmcnt(0)
    s_add_u32 s15, s15, s33
    v_mov_b32 v17, s15
    global_store_dword v14, v17, s[22:23]
    s_branch L_c2
L_vp0:
    s_branch L_vb
L_w4:
    s_waitcnt vmcnt(28)
    buffer_load_dwordx4 v8, s[16:19], s37 offen offset:0 nt lds
    s_waitcnt vmcnt(28)
    buffer_load_dwordx4 v9, s[16:19], s37 offen offset:1024 nt lds
    s_waitcnt vmcnt(27)
    buffer_load_dwordx4 v10, s[16:19], s37 offen offset:2048 nt lds
    s_waitcnt vmcnt(27)
    buffer_load_dwordx4 v11, s[16:19], s37 offen offset:3072 nt lds
    v_add_u32 v15, 1, v15
    s_add_u32 m0, m0, 4096
    s_add_u32 s37, s37, 16384
    global_store_dword v12, v15, s[22:23]
    s_andn2_b32 s15, 0xc000, s37
    s_cbranch_scc1 L_w4
    s_waitcnt vmcnt(28)
    buffer_load_dwordx4 v8, s[16:19], s37 offen offset:0 nt lds
    v_mov_b32 v17, v16
    s_nop 0
    v_readlane_b32 s36, v17, s24
    v_readlane_b32 s35, v17, 63
    s_nop 0
    v_subrev_u32 v17, s36, v17
    v_writelane_b32 v17, 0, 63
    s_waitcnt vmcnt(28)
    buffer_load_dwordx4 v9, s[16:19], s37 offen offset:1024 nt lds
    v_add_u32_dpp v17, v17, v17 row_shr:1 row_mask:0xf bank_mask:0xf bound_ctrl:1
    s_nop 1
    v_add_u32_dpp v17, v17, v17 row_shr:2 row_mask:0xf bank_mask:0xf bound_ctrl:1
    s_waitcnt vmcnt(27)
    buffer_load_dwordx4 v10, s[16:19], s37 offen offset:2048 nt lds
    v_add_u32_dpp v17, v17, v17 row_shr:4 row_mask:0xf bank_mask:0xf bound_ctrl:1
    s_nop 1
    v_add_u32_dpp v17, v17, v17 row_shr:8 row_mask:0xf bank_mask:0xf bound_ctrl:1
    s_waitcnt vmcnt(27)
    buffer_load_dwordx4 v11, s[16:19], s37 offen offset:3072 nt lds
    v_add_u32_dpp v17, v17, v17 row_bcast:15 row_mask:0xa bank_mask:0xf
    v_add_u32 v15, 1, v15
    s_add_u32 m0, m0, 4096
    v_add_u32_dpp v17, v17, v17 row_bcast:31 row_mask:0xc bank_mask:0xf
    s_branch L_se
L_vp1:
    s_branch L_vb
L_w2:
    s_waitcnt vmcnt(25)
    buffer_load_dwordx4 v8, s[16:19], s37 offen offset:0 nt lds
    s_waitcnt vmcnt(25)
    buffer_load_dwordx4 v9, s[16:19], s37 offen offset:1024 nt lds
    s_waitcnt vmcnt(25)
    buffer_load_dwordx4 v10, s[16:19], s37 offen offset:2048 nt lds
    s_waitcnt vmcnt(25)
    buffer_load_dwordx4 v11, s[16:19], s37 offen offset:3072 nt lds
    v_add_u32 v15, 1, v15
    s_add_u32 m0, m0, 4096
    s_add_u32 s37, s37, 16384
    global_store_dword v12, v15, s[22:23]
    s_andn2_b32 s15, 0xc000, s37
    s_cbranch_scc1 L_w2
    s_waitcnt vmcnt(25)
    buffer_load_dwordx4 v8, s[16:19], s37 offen offset:0 nt lds
    v_mov_b32 v17, v16
    s_nop 0
    v_readlane_b32 s36, v17, s24
    v_readlane_b32 s35, v17, 63
    s_nop 0
    v_subrev_u32 v17, s36, v17
    v_writelane_b32 v17, 0, 63
    s_waitcnt vmcnt(25)
    buffer_load_dwordx4 v9, s[16:19], s37 offen offset:1024 nt lds
    v_add_u32_dpp v17, v17, v17 row_shr:1 row_mask:0xf bank_mask:0xf bound_ctrl:1
    s_nop 1
    v_add_u32_dpp v17, v17, v17 row_shr:2 row_mask:0xf bank_mask:0xf bound_ctrl:1
    s_waitcnt vmcnt(25)
    buffer_load_dwordx4 v10, s[16:19], s37 offen offset:2048 nt lds
    v_add_u32_dpp v17, v17, v17 row_shr:4 row_mask:0xf bank_mask:0xf bound_ctrl:1
    s_nop 1
    v_add_u32_dpp v17, v17, v17 row_shr:8 row_mask:0xf bank_mask:0xf bound_ctrl:1
    s_waitcnt vmcnt(25)
    buffer_load_dwordx4 v11, s[16:19], s37 offen offset:3072 nt lds
    v_add_u32_dpp v17, v17, v17 row_bcast:15 row_mask:0xa bank_mask:0xf
    v_add_u32 v15, 1, v15
    s_add_u32 m0, m0, 4096
    v_add_u32_dpp v17, v17, v17 row_bcast:31 row_mask:0xc bank_mask:0xf
    s_branch L_se
L_vp2:
    s_branch L_vb
L_w5:
    s_waitcnt vmcnt(29)
    buffer_load_dwordx4 v8, s[16:19], s37 offen offset:0 nt lds
    s_waitcnt vmcnt(29)
    buffer_load_dwordx4 v9, s[16:19], s37 offen offset:1024 nt lds
    s_waitcnt vmcnt(29)
    buffer_load_dwordx4 v10, s[16:19], s37 offen offset:2048 nt lds
    s_waitcnt vmcnt(28)
    buffer_load_dwordx4 v11, s[16:19], s37 offen offset:3072 nt lds
    v_add_u32 v15, 1, v15
    s_add_u32 m0, m0, 4096
    s_add_u32 s37, s37, 16384
    global_store_dword v12, v15, s[22:23]
    s_andn2_b32 s15, 0xc000, s37
    s_cbranch_scc1 L_w5
    s_waitcnt vmcnt(29)
    buffer_load_dwordx4 v8, s[16:19], s37 offen offset:0 nt lds
    v_mov_b32 v17, v16
    s_nop 0
    v_readlane_b32 s36, v17, s24
    v_readlane_b32 s35, v17, 63
    s_nop 0
    v_subrev_u32 v17, s36, v17
    v_writelane_b32 v17, 0, 63
    s_waitcnt vmcnt(29)
    buffer_load_dwordx4 v9, s[16:19], s37 offen offset:1024 nt lds
    v_add_u32_dpp v17, v17, v17 row_shr:1 row_mask:0xf bank_mask:0xf bound_ctrl:1
    s_nop 1
    v_add_u32_dpp v17, v17, v17 row_shr:2 row_mask:0xf bank_mask:0xf bound_ctrl:1
    s_waitcnt vmcnt(29)
    buffer_load_dwordx4 v10, s[16:19], s37 offen offset:2048 nt lds
    v_add_u32_dpp v17, v17, v17 row_shr:4 row_mask:0xf bank_mask:0xf bound_ctrl:1
    s_nop 1
    v_add_u32_dpp v17, v17, v17 row_shr:8 row_mask:0xf bank_mask:0xf bound_ctrl:1
    s_waitcnt vmcnt(28)
    buffer_load_dwordx4 v11, s[16:19], s37 offen offset:3072 nt lds
    v_add_u32_dpp v17, v17, v17 row_bcast:15 row_mask:0xa bank_mask:0xf
    v_add_u32 v15, 1, v15
    s_add_u32 m0, m0, 4096
    v_add_u32_dpp v17, v17, v17 row_bcast:31 row_mask:0xc bank_mask:0xf
    s_branch L_se
L_vp3:
    s_branch L_vb
L_w1:
    s_waitcnt vmcnt(24)
    buffer_load_dwordx4 v8, s[16:19], s37 offen offset:0 nt lds
    s_waitcnt vmcnt(24)
    buffer_load_dwordx4 v9, s[16:19], s37 offen offset:1024 nt lds
    s_waitcnt vmcnt(24)
    buffer_load_dwordx4 v10, s[16:19], s37 offen offset:2048 nt lds
    s_waitcnt vmcnt(23)
    buffer_load_dwordx4 v11, s[16:19], s37 offen offset:3072 nt lds
    v_add_u32 v15, 1, v15
    s_add_u32 m0, m0, 4096
    s_add_u32 s37, s37, 16384
    global_store_dword v12, v15, s[22:23]
    s_andn2_b32 s15, 0xc000, s37
    s_cbranch_scc1 L_w1
    s_waitcnt vmcnt(24)
    buffer_load_dwordx4 v8, s[16:19], s37 offen offset:0 nt lds
    v_mov_b32 v17, v16
    s_nop 0
    v_readlane_b32 s36, v17, s24
    v_readlane_b32 s35, v17, 63
    s_nop 0
    v_subrev_u32 v17, s36, v17
    v_writelane_b32 v17, 0, 63
    s_waitcnt vmcnt(24)
    buffer_load_dwordx4 v9, s[16:19], s37 offen offset:1024 nt lds
    v_add_u32_dpp v17, v17, v17 row_shr:1 row_mask:0xf bank_mask:0xf bound_ctrl:1
    s_nop 1
    v_add_u32_dpp v17, v17, v17 row_shr:2 row_mask:0xf bank_mask:0xf bound_ctrl:1
    s_waitcnt vmcnt(24)
    buffer_load_dwordx4 v10, s[16:19], s37 offen offset:2048 nt lds
    v_add_u32_dpp v17, v17, v17 row_shr:4 row_mask:0xf bank_mask:0xf bound_ctrl:1
    s_nop 1
    v_add_u32_dpp v17, v17, v17 row_shr:8 row_mask:0xf bank_mask:0xf bound_ctrl:1
    s_waitcnt vmcnt(23)
    buffer_load_dwordx4 v11, s[16:19], s37 offen offset:3072 nt lds
    v_add_u32_dpp v17, v17, v17 row_bcast:15 row_mask:0xa bank_mask:0xf
    v_add_u32 v15, 1, v15
    s_add_u32 m0, m0, 4096
    v_add_u32_dpp v17, v17, v17 row_bcast:31 row_mask:0xc bank_mask:0xf
    s_branch L_se
L_vp4:
    s_branch L_vb
L_w6:
    s_waitcnt vmcnt(30)
    buffer_load_dwordx4 v8, s[16:19], s37 offen offset:0 nt lds
    s_waitcnt vmcnt(30)
    buffer_load_dwordx4 v9, s[16:19], s37 offen offset:1024 nt lds
    s_waitcnt vmcnt(30)
    buffer_load_dwordx4 v10, s[16:19], s37 offen offset:2048 nt lds
    s_waitcnt vmcnt(30)
    buffer_load_dwordx4 v11, s[16:19], s37 offen offset:3072 nt lds
    v_add_u32 v15, 1, v15
    s_add_u32 m0, m0, 4096
    s_add_u32 s37, s37, 16384
    global_store_dword v12, v15, s[22:23]
    s_andn2_b32 s15, 0xc000, s37
    s_cbranch_scc1 L_w6
    s_waitcnt vmcnt(30)
    buffer_load_dwordx4 v8, s[16:19], s37 offen offset:0 nt lds
    v_mov_b32 v17, v16
    s_nop 0
    v_readlane_b32 s36, v17, s24
    v_readlane_b32 s35, v17, 63
    s_nop 0
    v_subrev_u32 v17, s36, v17
    v_writelane_b32 v17, 0, 63
    s_waitcnt vmcnt(30)
    buffer_load_dwordx4 v9, s[16:19], s37 offen offset:1024 nt lds
    v_add_u32_dpp v17, v17, v17 row_shr:1 row_mask:0xf bank_mask:0xf bound_ctrl:1
    s_nop 1
    v_add_u32_dpp v17, v17, v17 row_shr:2 row_mask:0xf bank_mask:0xf bound_ctrl:1
    s_waitcnt vmcnt(30)
    buffer_load_dwordx4 v10, s[16:19], s37 offen offset:2048 nt lds
    v_add_u32_dpp v17, v17, v17 row_shr:4 row_mask:0xf bank_mask:0xf bound_ctrl:1
    s_nop 1
    v_add_u32_dpp v17, v17, v17 row_shr:8 row_mask:0xf bank_mask:0xf bound_ctrl:1
    s_waitcnt vmcnt(30)
    buffer_load_dwordx4 v11, s[16:19], s37 offen offset:3072 nt lds
    v_add_u32_dpp v17, v17, v17 row_bcast:15 row_mask:0xa bank_mask:0xf
    v_add_u32 v15, 1, v15
    s_add_u32 m0, m0, 4096
    v_add_u32_dpp v17, v17, v17 row_bcast:31 row_mask:0xc bank_mask:0xf
    s_branch L_se
L_vp5:
    s_branch L_vb
L_w0:
    s_waitcnt vmcnt(23)
    buffer_load_dwordx4 v8, s[16:19], s37 offen offset:0 nt lds
    s_waitcnt vmcnt(23)
    buffer_load_dwordx4 v9, s[16:19], s37 offen offset:1024 nt lds
    s_waitcnt vmcnt(22)
    buffer_load_dwordx4 v10, s[16:19], s37 offen offset:2048 nt lds
    s_waitcnt vmcnt(22)
    buffer_load_dwordx4 v11, s[16:19], s37 offen offset:3072 nt lds
    v_add_u32 v15, 1, v15
    s_add_u32 m0, m0, 4096
    s_add_u32 s37, s37, 16384
    global_store_dword v12, v15, s[22:23]
    s_andn2_b32 s15, 0xc000, s37
    s_cbranch_scc1 L_w0
    s_waitcnt vmcnt(23)
    buffer_load_dwordx4 v8, s[16:19], s37 offen offset:0 nt lds
    v_mov_b32 v17, v16
    s_nop 0
    v_readlane_b32 s36, v17, s24
    v_readlane_b32 s35, v17, 63
    s_nop 0
    v_subrev_u32 v17, s36, v17
    v_writelane_b32 v17, 0, 63
    s_waitcnt vmcnt(23)
    buffer_load_dwordx4 v9, s[16:19], s37 offen offset:1024 nt lds
    v_add_u32_dpp v17, v17, v17 row_shr:1 row_mask:0xf bank_mask:0xf bound_ctrl:1
    s_nop 1
    v_add_u32_dpp v17, v17, v17 row_shr:2 row_mask:0xf bank_mask:0xf bound_ctrl:1
    s_waitcnt vmcnt(22)
    buffer_load_dwordx4 v10, s[16:19], s37 offen offset:2048 nt lds
    v_add_u32_dpp v17, v17, v17 row_shr:4 row_mask:0xf bank_mask:0xf bound_ctrl:1
    s_nop 1
    v_add_u32_dpp v17, v17, v17 row_shr:8 row_mask:0xf bank_mask:0xf bound_ctrl:1
    s_waitcnt vmcnt(22)
    buffer_load_dwordx4 v11, s[16:19], s37 offen offset:3072 nt lds
    v_add_u32_dpp v17, v17, v17 row_bcast:15 row_mask:0xa bank_mask:0xf
    v_add_u32 v15, 1, v15
    s_add_u32 m0, m0, 4096
    v_add_u32_dpp v17, v17, v17 row_bcast:31 row_mask:0xc bank_mask:0xf
    s_branch L_se
L_vp6:
    s_branch L_vb
L_w7:
    s_waitcnt vmcnt(32)
    buffer_load_dwordx4 v8, s[16:19], s37 offen offset:0 nt lds
    s_waitcnt vmcnt(31)
    buffer_load_dwordx4 v9, s[16:19], s37 offen offset:1024 nt lds
    s_waitcnt vmcnt(31)
    buffer_load_dwordx4 v10, s[16:19], s37 offen offset:2048 nt lds
    s_waitcnt vmcnt(31)
    buffer_load_dwordx4 v11, s[16:19], s37 offen offset:3072 nt lds
    v_add_u32 v15, 1, v15
    s_add_u32 m0, m0, 4096
    s_add_u32 s37, s37, 16384
    global_store_dword v12, v15, s[22:23]
    s_andn2_b32 s15, 0xc000, s37
    s_cbranch_scc1 L_w7
    s_waitcnt vmcnt(32)
    buffer_load_dwordx4 v8, s[16:19], s37 offen offset:0 nt lds
    v_mov_b32 v17, v16
    s_nop 0
    v_readlane_b32 s36, v17, s24
    v_readlane_b32 s35, v17, 63
    s_nop 0
    v_subrev_u32 v17, s36, v17
    v_writelane_b32 v17, 0, 63
    s_waitcnt vmcnt(31)
    buffer_load_dwordx4 v9, s[16:19], s37 offen offset:1024 nt lds
    v_add_u32_dpp v17, v17, v17 row_shr:1 row_mask:0xf bank_mask:0xf bound_ctrl:1
    s_nop 1
    v_add_u32_dpp v17, v17, v17 row_shr:2 row_mask:0xf bank_mask:0xf bound_ctrl:1
    s_waitcnt vmcnt(31)
    buffer_load_dwordx4 v10, s[16:19], s37 offen offset:2048 nt lds
    v_add_u32_dpp v17, v17, v17 row_shr:4 row_mask:0xf bank_mask:0xf bound_ctrl:1
    s_nop 1
    v_add_u32_dpp v17, v17, v17 row_shr:8 row_mask:0xf bank_mask:0xf bound_ctrl:1
    s_waitcnt vmcnt(31)
    buffer_load_dwordx4 v11, s[16:19], s37 offen offset:3072 nt lds
    v_add_u32_dpp v17, v17, v17 row_bcast:15 row_mask:0xa bank_mask:0xf
    v_add_u32 v15, 1, v15
    s_add_u32 m0, m0, 4096
    v_add_u32_dpp v17, v17, v17 row_bcast:31 row_mask:0xc bank_mask:0xf
    s_branch L_se
L_vp7:
    s_branch L_vb
L_w8:
    s_waitcnt vmcnt(33)
    buffer_load_dwordx4 v8, s[16:19], s37 offen offset:0 nt lds
    s_waitcnt vmcnt(33)
    buffer_load_dwordx4 v9, s[16:19], s37 offen offset:1024 nt lds
    s_waitcnt vmcnt(32)
    buffer_load_dwordx4 v10, s[16:19], s37 offen offset:2048 nt lds
    s_waitcnt vmcnt(32)
    buffer_load_dwordx4 v11, s[16:19], s37 offen offset:3072 nt lds
    v_add_u32 v15, 1, v15
    s_add_u32 m0, m0, 4096
    s_add_u32 s37, s37, 16384
    global_store_dword v12, v15, s[22:23]
    s_andn2_b32 s15, 0xc000, s37
    s_cbranch_scc1 L_w8
    s_waitcnt vmcnt(33)
    buffer_load_dwordx4 v8, s[16:19], s37 offen offset:0 nt lds
    v_mov_b32 v17, v16
    s_nop 0
    v_readlane_b32 s36, v17, s24
    v_readlane_b32 s35, v17, 63
    s_nop 0
    v_subrev_u32 v17, s36, v17
    v_writelane_b32 v17, 0, 63
    s_waitcnt vmcnt(33)
    buffer_load_dwordx4 v9, s[16:19], s37 offen offset:1024 nt lds
    v_add_u32_dpp v17, v17, v17 row_shr:1 row_mask:0xf bank_mask:0xf bound_ctrl:1
    s_nop 1
    v_add_u32_dpp v17, v17, v17 row_shr:2 row_mask:0xf bank_mask:0xf bound_ctrl:1
    s_waitcnt vmcnt(32)
    buffer_load_dwordx4 v10, s[16:19], s37 offen offset:2048 nt lds
    v_add_u32_dpp v17, v17, v17 row_shr:4 row_mask:0xf bank_mask:0xf bound_ctrl:1
    s_nop 1
    v_add_u32_dpp v17, v17, v17 row_shr:8 row_mask:0xf bank_mask:0xf bound_ctrl:1
    s_waitcnt vmcnt(32)
    buffer_load_dwordx4 v11, s[16:19], s37 offen offset:3072 nt lds
    v_add_u32_dpp v17, v17, v17 row_bcast:15 row_mask:0xa bank_mask:0xf
    v_add_u32 v15, 1, v15
    s_add_u32 m0, m0, 4096
    v_add_u32_dpp v17, v17, v17 row_bcast:31 row_mask:0xc bank_mask:0xf
    s_branch L_se
L_w9:
    s_waitcnt vmcnt(34)
    buffer_load_dwordx4 v8, s[16:19], s37 offen offset:0 nt lds
    s_waitcnt vmcnt(34)
    buffer_load_dwordx4 v9, s[16:19], s37 offen offset:1024 nt lds
    s_waitcnt vmcnt(34)
    buffer_load_dwordx4 v10, s[16:19], s37 offen offset:2048 nt lds
    s_waitcnt vmcnt(33)
    buffer_load_dwordx4 v11, s[16:19], s37 offen offset:3072 nt lds
    v_add_u32 v15, 1, v15
    s_add_u32 m0, m0, 4096
    s_add_u32 s37, s37, 16384
    global_store_dword v12, v15, s[22:23]
    s_andn2_b32 s15, 0xc000, s37
    s_cbranch_scc1 L_w9
    s_waitcnt vmcnt(34)
    buffer_load_dwordx4 v8, s[16:19], s37 offen offset:0 nt lds
    v_mov_b32 v17, v16
    s_nop 0
    v_readlane_b32 s36, v17, s24
    v_readlane_b32 s35, v17, 63
    s_nop 0
    v_subrev_u32 v17, s36, v17
    v_writelane_b32 v17, 0, 63
    s_waitcnt vmcnt(34)
    buffer_load_dwordx4 v9, s[16:19], s37 offen offset:1024 nt lds
    v_add_u32_dpp v17, v17, v17 row_shr:1 row_mask:0xf bank_mask:0xf bound_ctrl:1
    s_nop 1
    v_add_u32_dpp v17, v17, v17 row_shr:2 row_mask:0xf bank_mask:0xf bound_ctrl:1
    s_waitcnt vmcnt(34)
    buffer_load_dwordx4 v10, s[16:19], s37 offen offset:2048 nt lds
    v_add_u32_dpp v17, v17, v17 row_shr:4 row_mask:0xf bank_mask:0xf bound_ctrl:1
    s_nop 1
    v_add_u32_dpp v17, v17, v17 row_shr:8 row_mask:0xf bank_mask:0xf bound_ctrl:1
    s_waitcnt vmcnt(33)
    buffer_load_dwordx4 v11, s[16:19], s37 offen offset:3072 nt lds
    v_add_u32_dpp v17, v17, v17 row_bcast:15 row_mask:0xa bank_mask:0xf
    v_add_u32 v15, 1, v15
    s_add_u32 m0, m0, 4096
    v_add_u32_dpp v17, v17, v17 row_bcast:31 row_mask:0xc bank_mask:0xf
    s_branch L_se
L_cons:
    s_load_dwordx2 s[12:13], s[0:1], 32
    s_load_dwordx4 s[68:71], s[0:1], 40
    s_sub_u32 s28, s3, 1
    v_and_b32 v1, 63, v0
    v_and_b32 v2, 15, v0
    v_lshrrev_b32 v3, 4, v1
    v_and_b32 v8, 0x3ff, v8
    s_mov_b32 s18, 0x4000
    s_mov_b32 s22, 0x100
    s_mov_b32 s23, 0x20000
    s_mov_b32 s26, 0x100
    s_mov_b32 s27, 0x20000
    s_lshl_b32 s15, s2, 8
    s_lshl_b32 s14, s28, 11
    s_add_u32 s38, s14, 131072
    s_and_b32 s39, s28, 1
    s_lshl_b32 s39, s39, 5
    v_xor_b32 v36, s39, v8
    v_xor_b32 v37, 16, v36
    v_lshlrev_b32 v38, 2, v1
    s_lshl_b32 s39, s2, 3
    s_add_u32 s39, s39, s28
    s_waitcnt lgkmcnt(0)
    s_mov_b32 s16, s10
    s_mov_b32 s17, s11
    s_add_u32 s20, s4, s15
    s_addc_u32 s21, s5, 0
    s_add_u32 s24, s12, s15
    s_addc_u32 s25, s13, 0
    buffer_load_dwordx4 v[44:47], v36, s[16:19], s14 offen
    buffer_load_dwordx4 v[48:51], v37, s[16:19], s14 offen offset:1024
    s_cmp_lg_u32 s28, 0
    s_cbranch_scc1 L_om2
    s_mov_b32 m0, 147456
    s_nop 0
    buffer_load_dword v38, s[20:23], 0 offen lds
L_om2:
    s_cmp_lg_u32 s39, 7
    s_cbranch_scc1 L_nz
    v_mul_u32_u24 v20, 768, v1
    v_add_u32 v20, 16384, v20
    v_mov_b32 v21, 0
    global_store_dword v20, v21, s[70:71] sc0 sc1
L_nz:
    v_mov_b32 v6, 0xbd8293ee
    v_xor_b32 v4, v3, v2
    v_lshlrev_b32 v4, 4, v4
    v_and_b32 v12, 3, v2
    v_lshrrev_b32 v13, 2, v2
    v_lshl_add_u32 v14, v12, 2, v13
    v_lshl_add_u32 v5, v14, 2, s38
    v_lshl_add_u32 v8, v14, 8, v4
    v_xor_b32 v9, 64, v8
    v_xor_b32 v10, 128, v8
    v_xor_b32 v11, 192, v8
    v_add_u32 v12, 131072, v8
    v_add_u32 v13, 131072, v9
    v_add_u32 v14, 131072, v10
    v_add_u32 v15, 131072, v11
    v_lshlrev_b32 v16, 4, v3
    v_add_u32 v16, 147456, v16
    v_lshl_add_u32 v17, v1, 4, s38
    s_lshl_b32 s29, s28, 12
    s_mov_b32 s36, 0
    s_mov_b32 s30, 32
    v_and_b32 v22, 1, v1
    v_lshlrev_b32 v22, 7, v22
    v_mov_b32 v23, 1
    s_cmp_eq_u32 s28, 0
    s_cbranch_scc1 L_vp0
    s_cmp_eq_u32 s28, 1
    s_cbranch_scc1 L_vp1
    s_cmp_eq_u32 s28, 2
    s_cbranch_scc1 L_vp2
    s_cmp_eq_u32 s28, 3
    s_cbranch_scc1 L_vp3
    s_cmp_eq_u32 s28, 4
    s_cbranch_scc1 L_vp4
    s_cmp_eq_u32 s28, 5
    s_cbranch_scc1 L_vp5
    s_cmp_eq_u32 s28, 6
    s_cbranch_scc1 L_vp6
    s_cmp_eq_u32 s28, 7
    s_cbranch_scc1 L_vp7
L_vb:
    s_waitcnt vmcnt(0)
    s_cmp_lg_u32 s39, 7
    s_cbranch_scc1 L_nf
    s_mov_b64 exec, 3
    global_store_dword v22, v23, s[68:69] sc0 sc1
    s_mov_b64 exec, -1
L_nf:
    v_lshlrev_b32 v21, 4, v1
    v_add_u32 v21, 147968, v21
    s_mov_b32 s15, 0x3edb9ada
    v_lshlrev_b32 v60, 16, v44
    v_and_b32 v61, 0xffff0000, v44
    v_lshlrev_b32 v62, 16, v45
    v_and_b32 v63, 0xffff0000, v45
    v_lshlrev_b32 v64, 16, v46
    v_and_b32 v65, 0xffff0000, v46
    v_lshlrev_b32 v66, 16, v47
    v_and_b32 v67, 0xffff0000, v47
    v_lshlrev_b32 v68, 16, v48
    v_and_b32 v69, 0xffff0000, v48
    v_lshlrev_b32 v70, 16, v49
    v_and_b32 v71, 0xffff0000, v49
    v_lshlrev_b32 v72, 16, v50
    v_and_b32 v73, 0xffff0000, v50
    v_lshlrev_b32 v74, 16, v51
    v_and_b32 v75, 0xffff0000, v51
    v_mul_f32 v60, s15, v60
    v_mul_f32 v61, s15, v61
    v_mul_f32 v62, s15, v62
    v_mul_f32 v63, s15, v63
    v_mul_f32 v64, s15, v64
    v_mul_f32 v65, s15, v65
    v_mul_f32 v66, s15, v66
    v_mul_f32 v67, s15, v67
    v_mul_f32 v68, s15, v68
    v_mul_f32 v69, s15, v69
    v_mul_f32 v70, s15, v70
    v_mul_f32 v71, s15, v71
    v_mul_f32 v72, s15, v72
    v_mul_f32 v73, s15, v73
    v_mul_f32 v74, s15, v74
    v_mul_f32 v75, s15, v75
    v_cvt_pk_bf16_f32 v44, v60, v61
    v_cvt_pk_bf16_f32 v45, v62, v63
    v_cvt_pk_bf16_f32 v46, v64, v65
    v_cvt_pk_bf16_f32 v47, v66, v67
    v_cvt_pk_bf16_f32 v48, v68, v69
    v_cvt_pk_bf16_f32 v49, v70, v71
    v_cvt_pk_bf16_f32 v50, v72, v73
    v_cvt_pk_bf16_f32 v51, v74, v75
    ds_write_b128 v17, v[44:47]
    ds_write_b128 v17, v[48:51] offset:1024
    s_lshl_b32 s14, s2, 20
    s_add_u32 s8, s8, s14
    s_addc_u32 s9, s9, 0
    v_mov_b32 v18, 0
    global_load_dword v7, v18, s[8:9] nt
    s_waitcnt lgkmcnt(0)
    s_barrier
    ds_read_b128 v[76:79], v12 offset:0
    ds_read_b128 v[80:83], v12 offset:4096
    ds_read_b128 v[84:87], v12 offset:8192
    ds_read_b128 v[88:91], v12 offset:12288
    ds_read_b128 v[92:95], v13 offset:0
    ds_read_b128 v[96:99], v13 offset:4096
    ds_read_b128 v[100:103], v13 offset:8192
    ds_read_b128 v[104:107], v13 offset:12288
    ds_read_b128 v[108:111], v14 offset:0
    ds_read_b128 v[112:115], v14 offset:4096
    ds_read_b128 v[116:119], v14 offset:8192
    ds_read_b128 v[120:123], v14 offset:12288
    s_waitcnt lgkmcnt(4)
    ds_read_b128 v[124:127], v15 offset:0
    ds_read_b128 v[128:131], v15 offset:4096
    ds_read_b128 v[132:135], v15 offset:8192
    ds_read_b128 v[136:139], v15 offset:12288
    s_cmp_lg_u32 s28, 0
    s_cbranch_scc1 L_k0
    ds_read_b128 v[44:47], v16 offset:0
    ds_read_b128 v[48:51], v16 offset:64
    ds_read_b128 v[52:55], v16 offset:128
    ds_read_b128 v[56:59], v16 offset:192
    s_branch L_front
L_phiq:
    v_mov_b32 v13, 0x358637bd
    v_mov_b32 v14, 0x3e000000
    v_fma_f32 v60, v60, v14, v13
    v_fma_f32 v61, v61, v14, v13
    v_fma_f32 v62, v62, v14, v13
    v_fma_f32 v63, v63, v14, v13
    v_fma_f32 v64, v64, v14, v13
    v_fma_f32 v65, v65, v14, v13
    v_fma_f32 v66, v66, v14, v13
    v_fma_f32 v67, v67, v14, v13
    v_fma_f32 v68, v68, v14, v13
    v_fma_f32 v69, v69, v14, v13
    v_fma_f32 v70, v70, v14, v13
    v_fma_f32 v71, v71, v14, v13
    v_fma_f32 v72, v72, v14, v13
    v_fma_f32 v73, v73, v14, v13
    v_fma_f32 v74, v74, v14, v13
    v_fma_f32 v75, v75, v14, v13
    v_mul_f32 v60, v60, v14
    v_mul_f32 v61, v61, v14
    v_mul_f32 v62, v62, v14
    v_mul_f32 v63, v63, v14
    v_mul_f32 v64, v64, v14
    v_mul_f32 v65, v65, v14
    v_mul_f32 v66, v66, v14
    v_mul_f32 v67, v67, v14
    v_mul_f32 v68, v68, v14
    v_mul_f32 v69, v69, v14
    v_mul_f32 v70, v70, v14
    v_mul_f32 v71, v71, v14
    v_mul_f32 v72, v72, v14
    v_mul_f32 v73, v73, v14
    v_mul_f32 v74, v74, v14
    v_mul_f32 v75, v75, v14
    v_cvt_pk_bf16_f32 v28, v60, v61
    v_cvt_pk_bf16_f32 v29, v62, v63
    v_cvt_pk_bf16_f32 v30, v64, v65
    v_cvt_pk_bf16_f32 v31, v66, v67
    v_cvt_pk_bf16_f32 v32, v68, v69
    v_cvt_pk_bf16_f32 v33, v70, v71
    v_cvt_pk_bf16_f32 v34, v72, v73
    v_cvt_pk_bf16_f32 v35, v74, v75
    v_mov_b32 v16, 0x3f803f80
    v_mov_b32 v17, v16
    v_mov_b32 v18, v16
    v_mov_b32 v19, v16
    v_cmp_eq_u32 vcc, 0, v2
    s_nop 0
    v_mfma_f32_16x16x32_bf16 v[24:27], v[16:19], v[28:31], 0
    v_mfma_f32_16x16x32_bf16 v[24:27], v[16:19], v[32:35], v[24:27]
    v_cndmask_b32 v36, 0, v28, vcc
    v_cndmask_b32 v37, 0, v29, vcc
    v_cndmask_b32 v38, 0, v30, vcc
    v_cndmask_b32 v39, 0, v31, vcc
    v_cndmask_b32 v40, 0, v32, vcc
    v_cndmask_b32 v41, 0, v33, vcc
    v_cndmask_b32 v42, 0, v34, vcc
    v_cndmask_b32 v43, 0, v35, vcc
    v_mul_f32 v22, 0x370637bd, v24
    v_mov_b32 v23, 147776
    ds_write_b128 v21, v[36:39]
    ds_write_b128 v21, v[40:43] offset:1024
    ds_write_b32 v23, v22
L_k0:
    s_mov_b32 s36, 1
    v_add_u32 v12, s29, v8
    v_add_u32 v13, s29, v9
    v_add_u32 v14, s29, v10
    v_add_u32 v15, s29, v11
    s_add_u32 s29, s29, 0x8000
    s_and_b32 s29, s29, 0x1ffff
    s_branch L_k1
L_phi:
    ds_read_b128 v[28:31], v21
    ds_read_b128 v[32:35], v21 offset:1024
    s_waitcnt lgkmcnt(0)
    s_branch L_kw
.p2align 3
L_k:
    s_barrier
    s_cmp_eq_u32 s30, 31
    s_cbranch_scc1 L_phi
L_kw:
    v_mfma_f32_16x16x32_bf16 v[24:27], v[28:31], v[36:39], 0
    v_mfma_f32_16x16x32_bf16 v[24:27], v[32:35], v[40:43], v[24:27]
    v_add_u32 v12, s29, v8
    v_add_u32 v13, s29, v9
    v_add_u32 v14, s29, v10
    v_add_u32 v15, s29, v11
    s_add_u32 s29, s29, 0x8000
    s_and_b32 s29, s29, 0x1ffff
    s_mov_b64 exec, 0xffff
    s_nop 0
    ds_write_b32 v5, v24
    s_mov_b64 exec, -1
    v_add_u32 v5, 64, v5
L_k1:
    ds_read_b128 v[44:47], v12
    ds_read_b128 v[48:51], v13
    ds_read_b128 v[52:55], v14
    ds_read_b128 v[56:59], v15
L_front:
    s_waitcnt lgkmcnt(3)
    v_dot2_f32_bf16 v20, v44, v44, 0
    v_dot2_f32_bf16 v20, v45, v45, v20
    v_dot2_f32_bf16 v20, v46, v46, v20
    v_dot2_f32_bf16 v20, v47, v47, v20
    s_waitcnt lgkmcnt(2)
    v_dot2_f32_bf16 v20, v48, v48, v20
    v_dot2_f32_bf16 v20, v49, v49, v20
    v_dot2_f32_bf16 v20, v50, v50, v20
    v_dot2_f32_bf16 v20, v51, v51, v20
    s_waitcnt lgkmcnt(1)
    v_dot2_f32_bf16 v20, v52, v52, v20
    v_dot2_f32_bf16 v20, v53, v53, v20
    v_dot2_f32_bf16 v20, v54, v54, v20
    v_dot2_f32_bf16 v20, v55, v55, v20
    s_waitcnt lgkmcnt(0)
    v_dot2_f32_bf16 v20, v56, v56, v20
    v_dot2_f32_bf16 v20, v57, v57, v20
    v_dot2_f32_bf16 v20, v58, v58, v20
    v_dot2_f32_bf16 v20, v59, v59, v20
    s_nop 2
    v_mfma_f32_16x16x4_f32 v[24:27], v6, v20, 0
    s_nop 9
    v_mfma_f32_16x16x32_bf16 v[60:63], v[76:79], v[44:47], v[24:27]
    v_mfma_f32_16x16x32_bf16 v[60:63], v[92:95], v[48:51], v[60:63]
    v_mfma_f32_16x16x32_bf16 v[60:63], v[108:111], v[52:55], v[60:63]
    v_mfma_f32_16x16x32_bf16 v[60:63], v[124:127], v[56:59], v[60:63]
    v_mfma_f32_16x16x32_bf16 v[64:67], v[80:83], v[44:47], v[24:27]
    v_mfma_f32_16x16x32_bf16 v[64:67], v[96:99], v[48:51], v[64:67]
    v_mfma_f32_16x16x32_bf16 v[64:67], v[112:115], v[52:55], v[64:67]
    v_mfma_f32_16x16x32_bf16 v[64:67], v[128:131], v[56:59], v[64:67]
    v_mfma_f32_16x16x32_bf16 v[68:71], v[84:87], v[44:47], v[24:27]
    v_mfma_f32_16x16x32_bf16 v[68:71], v[100:103], v[48:51], v[68:71]
    v_mfma_f32_16x16x32_bf16 v[68:71], v[116:119], v[52:55], v[68:71]
    v_mfma_f32_16x16x32_bf16 v[68:71], v[132:135], v[56:59], v[68:71]
    v_mfma_f32_16x16x32_bf16 v[72:75], v[88:91], v[44:47], v[24:27]
    v_mfma_f32_16x16x32_bf16 v[72:75], v[104:107], v[48:51], v[72:75]
    v_mfma_f32_16x16x32_bf16 v[72:75], v[120:123], v[52:55], v[72:75]
    v_mfma_f32_16x16x32_bf16 v[72:75], v[136:139], v[56:59], v[72:75]
    v_exp_f32 v60, v60
    v_exp_f32 v61, v61
    v_exp_f32 v62, v62
    v_exp_f32 v63, v63
    v_exp_f32 v64, v64
    v_exp_f32 v65, v65
    v_exp_f32 v66, v66
    v_exp_f32 v67, v67
    v_exp_f32 v68, v68
    v_exp_f32 v69, v69
    v_exp_f32 v70, v70
    v_exp_f32 v71, v71
    v_exp_f32 v72, v72
    v_exp_f32 v73, v73
    v_exp_f32 v74, v74
    v_exp_f32 v75, v75
    s_cmp_eq_u32 s36, 0
    s_cbranch_scc1 L_phiq
    v_cvt_pk_bf16_f32 v36, v60, v61
    v_cvt_pk_bf16_f32 v37, v62, v63
    v_cvt_pk_bf16_f32 v38, v64, v65
    v_cvt_pk_bf16_f32 v39, v66, v67
    v_cvt_pk_bf16_f32 v40, v68, v69
    v_cvt_pk_bf16_f32 v41, v70, v71
    v_cvt_pk_bf16_f32 v42, v72, v73
    v_cvt_pk_bf16_f32 v43, v74, v75
    s_sub_u32 s30, s30, 1
    s_cmp_lg_u32 s30, 0
    s_cbranch_scc1 L_k
    s_barrier
    v_mfma_f32_16x16x32_bf16 v[24:27], v[28:31], v[36:39], 0
    v_mfma_f32_16x16x32_bf16 v[24:27], v[32:35], v[40:43], v[24:27]
    v_mov_b32 v23, 147776
    ds_read_b32 v22, v23
    s_mov_b64 exec, 0xffff
    s_nop 4
    ds_write_b32 v5, v24
    s_mov_b64 exec, -1
    v_mov_b32 v76, 0
    v_mov_b32 v77, 0
    v_mov_b32 v78, 0
    v_mov_b32 v79, 0
    v_mov_b32 v85, 0
    v_mov_b32 v86, 1.0
    v_and_b32 v12, 1, v2
    v_lshlrev_b32 v12, 4, v12
    v_mov_b32 v13, 0xffff
    v_lshlrev_b32 v12, v12, v13
    v_bfe_u32 v13, v2, 1, 2
    v_cmp_eq_u32 s[40:41], 0, v13
    v_cmp_eq_u32 s[42:43], 1, v13
    v_cmp_eq_u32 s[44:45], 2, v13
    v_cmp_eq_u32 s[46:47], 3, v13
    v_lshrrev_b32 v14, 3, v2
    v_cvt_f32_u32 v84, v14
    v_cndmask_b32 v80, 0, v12, s[40:41]
    v_cndmask_b32 v81, 0, v12, s[42:43]
    v_cndmask_b32 v82, 0, v12, s[44:45]
    v_cndmask_b32 v83, 0, v12, s[46:47]
    v_lshl_add_u32 v8, v3, 10, v4
    v_xor_b32 v9, 320, v8
    v_xor_b32 v10, 640, v8
    v_xor_b32 v11, 960, v8
    v_lshl_add_u32 v5, v3, 4, s38
    s_mov_b32 s30, 32
    v_and_b32 v92, 1, v3
    v_lshlrev_b32 v92, 3, v92
    v_lshl_add_u32 v92, v2, 4, v92
    v_lshrrev_b32 v94, 1, v3
    v_lshl_add_u32 v94, v94, 2, v92
    v_mov_b32 v93, 147712
    s_lshl_b32 s15, s28, 10
    v_lshl_add_u32 v95, v1, 4, s15
    s_lshl_b32 s15, s28, 2
    s_add_u32 s15, s15, 147712
    v_mov_b32 v20, s15
    v_and_b32 v12, 1, v3
    v_lshlrev_b32 v12, 11, v12
    v_lshrrev_b32 v13, 1, v3
    v_lshl_add_u32 v12, v13, 13, v12
    v_lshl_add_u32 v12, v2, 4, v12
    s_lshl_b32 s15, s28, 14
    s_add_u32 s15, s15, 0xe1400
    v_add_u32 v21, s15, v12
    s_cmp_ge_u32 s28, 4
    s_cselect_b32 s33, 3, -1
    s_cselect_b32 s35, 1, -1
    s_cmp_eq_u32 s28, 7
    s_cselect_b32 s33, -1, s33
    s_cselect_b32 s34, 2, -1
    s_waitcnt lgkmcnt(0)
    v_readfirstlane_b32 s32, v22
.p2align 3
L_v:
    ds_read_b128 v[88:91], v5
    v_add_u32 v5, 64, v5
    v_add_u32 v16, s29, v8
    v_add_u32 v17, s29, v9
    v_add_u32 v18, s29, v10
    v_add_u32 v19, s29, v11
    s_add_u32 s29, s29, 0x8000
    s_and_b32 s29, s29, 0x1ffff
    s_waitcnt lgkmcnt(0)
    v_add_f32 v88, s32, v88
    v_add_f32 v89, s32, v89
    v_add_f32 v90, s32, v90
    v_add_f32 v91, s32, v91
    v_cvt_pk_bf16_f32 v12, 0, v88
    v_cvt_pk_bf16_f32 v13, 0, v89
    v_cvt_pk_bf16_f32 v14, 0, v90
    v_cvt_pk_bf16_f32 v15, 0, v91
    v_fma_f32 v12, -v12, v84, v88
    v_fma_f32 v13, -v13, v84, v89
    v_fma_f32 v14, -v14, v84, v90
    v_fma_f32 v15, -v15, v84, v91
    v_add_f32 v88, v88, v89
    v_add_f32 v90, v90, v91
    v_add_f32 v85, v85, v88
    v_add_f32 v85, v85, v90
    v_cvt_pk_bf16_f32 v12, v12, v12
    v_cvt_pk_bf16_f32 v13, v13, v13
    v_cvt_pk_bf16_f32 v14, v14, v14
    v_cvt_pk_bf16_f32 v15, v15, v15
    v_mfma_f32_16x16x4_f32 v[24:27], v86, v85, 0
    v_and_b32 v60, v12, v80
    v_and_b32 v61, v12, v81
    v_and_b32 v62, v12, v82
    v_and_b32 v63, v12, v83
    v_and_b32 v64, v13, v80
    v_and_b32 v65, v13, v81
    v_and_b32 v66, v13, v82
    v_and_b32 v67, v13, v83
    v_and_b32 v68, v14, v80
    v_and_b32 v69, v14, v81
    v_and_b32 v70, v14, v82
    v_and_b32 v71, v14, v83
    v_and_b32 v72, v15, v80
    v_and_b32 v73, v15, v81
    v_and_b32 v74, v15, v82
    v_and_b32 v75, v15, v83
    ds_write_b32 v20, v24
    s_cmp_eq_u32 s30, 32
    s_cbranch_scc1 L_v1
    s_waitcnt lgkmcnt(0)
    s_barrier
    s_cmp_eq_u32 s30, s33
    s_cbranch_scc1 L_d1
    s_cmp_eq_u32 s30, s35
    s_cbranch_scc1 L_d3
L_v1:
    ds_read_b128 v[44:47], v16
    ds_read_b128 v[48:51], v17
    ds_read_b128 v[52:55], v18
    ds_read_b128 v[56:59], v19
    s_sub_u32 s30, s30, 1
    s_waitcnt lgkmcnt(3)
    v_mfma_f32_16x16x32_bf16 v[76:79], v[60:63], v[44:47], v[76:79]
    s_waitcnt lgkmcnt(2)
    v_mfma_f32_16x16x32_bf16 v[76:79], v[64:67], v[48:51], v[76:79]
    s_waitcnt lgkmcnt(1)
    v_mfma_f32_16x16x32_bf16 v[76:79], v[68:71], v[52:55], v[76:79]
    s_waitcnt lgkmcnt(0)
    v_mfma_f32_16x16x32_bf16 v[76:79], v[72:75], v[56:59], v[76:79]
    s_cmp_eq_u32 s30, s34
    s_cbranch_scc1 L_d2
    s_cmp_lg_u32 s30, 0
    s_cbranch_scc1 L_v
L_wr:
    s_nop 6
    ds_write_b128 v95, v[76:79]
    s_waitcnt lgkmcnt(0)
    s_barrier
    s_endpgm
L_d1:
    global_load_dwordx4 v[124:127], v21, s[8:9] offset:0 nt
    global_load_dwordx4 v[128:131], v21, s[8:9] offset:256 nt
    global_load_dwordx4 v[132:135], v21, s[8:9] offset:512 nt
    global_load_dwordx4 v[136:139], v21, s[8:9] offset:768 nt
    s_branch L_v1
L_d2:
    global_load_dwordx4 v[124:127], v21, s[8:9] offset:0 nt
    global_load_dwordx4 v[128:131], v21, s[8:9] offset:256 nt
    global_load_dwordx4 v[132:135], v21, s[8:9] offset:512 nt
    global_load_dwordx4 v[136:139], v21, s[8:9] offset:768 nt
    s_branch L_v
L_d3:
    s_cmp_eq_u32 s28, 7
    s_cbranch_scc1 L_fin
    s_waitcnt vmcnt(3)
    v_mfma_f32_16x16x32_bf16 v[76:79], v[60:63], v[124:127], v[76:79]
    s_waitcnt vmcnt(2)
    v_mfma_f32_16x16x32_bf16 v[76:79], v[64:67], v[128:131], v[76:79]
    s_waitcnt vmcnt(1)
    v_mfma_f32_16x16x32_bf16 v[76:79], v[68:71], v[132:135], v[76:79]
    s_waitcnt vmcnt(0)
    v_mfma_f32_16x16x32_bf16 v[76:79], v[72:75], v[136:139], v[76:79]
    s_branch L_wr
L_fin:
    ds_read_b128 v[36:39], v93 offset:0
    ds_read_b128 v[40:43], v93 offset:16
    v_lshlrev_b32 v12, 4, v1
    s_waitcnt lgkmcnt(0)
    v_pk_add_f32 v[36:37], v[36:37], v[38:39]
    v_pk_add_f32 v[40:41], v[40:41], v[42:43]
    v_pk_add_f32 v[36:37], v[36:37], v[40:41]
    v_add_f32 v36, v36, v37
    v_add_f32 v36, 0x358637bd, v36
    v_rcp_f32 v37, v36
    s_barrier
    ds_read_b128 v[96:99], v12 offset:0
    ds_read_b128 v[100:103], v12 offset:1024
    ds_read_b128 v[104:107], v12 offset:2048
    ds_read_b128 v[108:111], v12 offset:3072
    ds_read_b128 v[112:115], v12 offset:4096
    ds_read_b128 v[116:119], v12 offset:5120
    ds_read_b128 v[120:123], v12 offset:6144
    s_waitcnt lgkmcnt(5)
    v_pk_add_f32 v[96:97], v[96:97], v[100:101]
    v_pk_add_f32 v[98:99], v[98:99], v[102:103]
    s_waitcnt lgkmcnt(4)
    v_pk_add_f32 v[96:97], v[96:97], v[104:105]
    v_pk_add_f32 v[98:99], v[98:99], v[106:107]
    s_waitcnt lgkmcnt(3)
    v_pk_add_f32 v[96:97], v[96:97], v[108:109]
    v_pk_add_f32 v[98:99], v[98:99], v[110:111]
    s_waitcnt lgkmcnt(2)
    v_pk_add_f32 v[96:97], v[96:97], v[112:113]
    v_pk_add_f32 v[98:99], v[98:99], v[114:115]
    s_waitcnt lgkmcnt(1)
    v_pk_add_f32 v[96:97], v[96:97], v[116:117]
    v_pk_add_f32 v[98:99], v[98:99], v[118:119]
    s_waitcnt lgkmcnt(0)
    v_pk_add_f32 v[96:97], v[96:97], v[120:121]
    v_pk_add_f32 v[98:99], v[98:99], v[122:123]
    v_pk_add_f32 v[96:97], v[96:97], v[76:77]
    v_pk_add_f32 v[98:99], v[98:99], v[78:79]
    s_waitcnt vmcnt(3)
    s_nop 0
    v_mfma_f32_16x16x32_bf16 v[96:99], v[60:63], v[124:127], v[96:99]
    s_waitcnt vmcnt(2)
    v_mfma_f32_16x16x32_bf16 v[96:99], v[64:67], v[128:131], v[96:99]
    s_waitcnt vmcnt(1)
    v_mfma_f32_16x16x32_bf16 v[96:99], v[68:71], v[132:135], v[96:99]
    s_waitcnt vmcnt(0)
    v_mfma_f32_16x16x32_bf16 v[96:99], v[72:75], v[136:139], v[96:99]
    s_nop 7
    v_permlane32_swap_b32 v96, v98
    v_permlane32_swap_b32 v97, v99
    v_pk_add_f32 v[96:97], v[96:97], v[98:99]
    v_mul_f32 v96, v96, v37
    v_mul_f32 v97, v97, v37
    v_cvt_pk_bf16_f32 v96, v96, v97
    buffer_store_dword v96, v94, s[24:27], 0 offen
L_done:
    s_endpgm
.section .rodata,"a"
.p2align 6
.amdhsa_kernel standalone__linear_kernel_rfa__decode_kernel
  .amdhsa_next_free_vgpr 140
  .amdhsa_next_free_sgpr 72
  .amdhsa_accum_offset 140
  .amdhsa_group_segment_fixed_size 0
  .amdhsa_kernarg_size 56
  .amdhsa_user_sgpr_count 2
  .amdhsa_user_sgpr_kernarg_segment_ptr 1
  .amdhsa_system_sgpr_workgroup_id_x 1
  .amdhsa_float_denorm_mode_32 3
.end_amdhsa_kernel
```
